```python
import torch

def _softmax(x, axis=-1):
    return torch.softmax(x, dim=axis)

def _gelu(x):
    return torch.nn.functional.gelu(x, approximate='tanh')

def _silu(x):
    return torch.nn.functional.silu(x)

def _sigmoid(x):
    return torch.sigmoid(x)

def _layernorm(x, axis=-1, eps=1e-05):
    m = x.mean(dim=axis, keepdim=True)
    v = x.var(dim=axis, keepdim=True, unbiased=False)
    return (x - m) / torch.sqrt(v + eps)

def _scatter_add(tgt, idx, src, axis=0):
    return tgt.clone().index_add_(axis, idx, src)

def _segment_sum(src, seg, n):
    out = torch.zeros((n,) + src.shape[1:], dtype=src.dtype)
    return out.index_add_(0, seg, src)

def _pad(x, pw):
    flat = tuple((v for pair in reversed(pw) for v in pair))
    return torch.nn.functional.pad(x, flat)
kernel_name = 'standalone__tree_speculative_verify_tree_attention_over_candidate_token_tree__sampling'

def setup_inputs():

    _w = lambda a: (lambda t: t.to(torch.bfloat16) if t.is_floating_point() else t)(torch.as_tensor(a))
    B, Hq, Hkv, T, C, D = (8, 32, 16, 1, 8192, 128)
    tree_mask = torch.zeros((B, T, T), dtype=float)
    for b in range(B):
        parent = torch.zeros(T, dtype=torch.int64)
        for i in range(1, T):
            parent[i] = int(torch.randint(0, i, (1,)).item())
        for i in range(T):
            j = i
            tree_mask[b, i, j] = 1.0
            while j > 0:
                j = parent[j]
                tree_mask[b, i, j] = 1.0
    return {'q': _w((lambda *s: torch.randn(*s, dtype=torch.bfloat16) * 0.8)(B, Hq, T, D)), 'k_cache': _w((lambda *s: torch.randn(*s, dtype=torch.bfloat16) * 0.8)(B, Hkv, C, D)), 'v_cache': _w((lambda *s: torch.randn(*s, dtype=torch.bfloat16) * 0.05)(B, Hkv, C, D)), 'k_tree': _w((lambda *s: torch.randn(*s, dtype=torch.bfloat16) * 0.8)(B, Hkv, T, D)), 'v_tree': _w((lambda *s: torch.randn(*s, dtype=torch.bfloat16) * 0.05)(B, Hkv, T, D)), 'tree_mask': _w(tree_mask)}

def reference(q, k_cache, v_cache, k_tree, v_tree, tree_mask):
    B, Hq, T, D = q.shape
    Hkv, C = (k_cache.shape[1], k_cache.shape[2])
    rep = Hq // Hkv
    kc = (lambda x, n, axis: torch.repeat_interleave(x, n, dim=axis))(k_cache, rep, axis=1)
    vc = (lambda x, n, axis: torch.repeat_interleave(x, n, dim=axis))(v_cache, rep, axis=1)
    kt = (lambda x, n, axis: torch.repeat_interleave(x, n, dim=axis))(k_tree, rep, axis=1)
    vt = (lambda x, n, axis: torch.repeat_interleave(x, n, dim=axis))(v_tree, rep, axis=1)
    k = torch.concatenate([kc, kt], axis=2)
    v = torch.concatenate([vc, vt], axis=2)
    scale = D ** (-0.5)
    scores = torch.einsum('bhqd,bhkd->bhqk', q, k) * scale
    ctx_mask = torch.ones((B, 1, T, C), dtype=scores.dtype)
    tm = tree_mask[:, None, :, :].clone()
    full_mask = torch.concatenate([ctx_mask, tm], axis=-1)
    scores = scores + (1.0 - full_mask) * -1000000000.0
    p = _softmax(scores, axis=-1)
    return torch.einsum('bhqk,bhkd->bhqd', p, v)
```

```asm
; @launch grid=(256,1,1) block=(64,1,1) lds=4096
.amdgcn_target "amdgcn-amd-amdhsa--gfx950"
.text
.globl standalone__tree_speculative_verify_tree_attention_over_candidate_token_tree__sampling_kernel
.p2align 8
.type standalone__tree_speculative_verify_tree_attention_over_candidate_token_tree__sampling_kernel,@function
standalone__tree_speculative_verify_tree_attention_over_candidate_token_tree__sampling_kernel:
    s_cmp_ge_u32 s2, 256
    s_cbranch_scc1 L_end
    s_load_dwordx16 s[24:39], s[0:1], 0
    s_load_dwordx2 s[40:41], s[0:1], 64
    s_and_b32 s3, s2, 127
    s_lshr_b32 s4, s2, 7
    v_mov_b32 v3, v0
    s_mov_b32 s5, 0
    v_and_b32 v6, 3, v3
    v_lshlrev_b32 v6, 10, v6
    v_bfe_u32 v7, v3, 2, 2
    v_lshl_add_u32 v6, v7, 8, v6
    v_lshrrev_b32 v10, 4, v3
    v_lshl_add_u32 v1, v10, 4, v6
    v_lshlrev_b32 v2, 4, v3
    v_and_b32 v7, 1, v3
    v_lshlrev_b32 v7, 8, v7
    v_lshl_add_u32 v11, v10, 4, v7
    s_lshl_b32 s44, s3, 21
    s_mul_i32 s45, s4, 65536
    s_add_u32 s44, s44, s45
    s_lshl_b32 s20, s5, 13
    s_add_u32 s21, s20, 4096
    s_mov_b32 s46, 0
    s_mov_b32 s62, 73728
    s_mov_b32 s63, 8192
    s_lshl_b32 s45, s3, 9
    s_mov_b32 s10, 0x00200000
    s_mov_b32 s11, 0x00020000
    s_mov_b32 s14, 0x00200000
    s_mov_b32 s15, 0x00020000
    s_mov_b32 s18, 512
    s_mov_b32 s19, 0x00020000
    s_xor_b32 s60, s5, 0
    s_or_b32 s60, s60, s4
    v_and_b32 v8, 31, v3
    v_lshlrev_b32 v8, 3, v8
    v_lshrrev_b32 v9, 5, v3
    v_lshl_add_u32 v12, v9, 8, v8
    v_bfe_u32 v9, v3, 3, 2
    v_lshlrev_b32 v9, 6, v9
    v_and_b32 v6, 7, v3
    v_lshl_add_u32 v9, v6, 1, v9
    s_waitcnt lgkmcnt(0)
    s_add_u32 s8, s26, s44
    s_addc_u32 s9, s27, 0
    s_add_u32 s12, s28, s44
    s_addc_u32 s13, s29, 0
    s_add_u32 s16, s24, s45
    s_addc_u32 s17, s25, 0
    s_cmp_lg_u32 s60, 0
    s_cbranch_scc1 L_notree1
    buffer_load_dwordx2 v[48:49], v12, s[16:19], 0 offen
    s_lshl_b32 s45, s3, 8
    s_add_u32 s56, s30, s45
    s_addc_u32 s57, s31, 0
    s_mov_b32 s58, 256
    s_mov_b32 s59, 0x00020000
    buffer_load_dwordx2 v[50:51], v8, s[56:59], 0 offen
    s_add_u32 s56, s32, s45
    s_addc_u32 s57, s33, 0
    buffer_load_ushort v52, v9, s[56:59], 0 offen offset:0
    buffer_load_ushort v53, v9, s[56:59], 0 offen offset:16
    buffer_load_ushort v54, v9, s[56:59], 0 offen offset:32
    buffer_load_ushort v55, v9, s[56:59], 0 offen offset:48
    s_mov_b32 s56, s34
    s_mov_b32 s57, s35
    s_mov_b32 s58, 16
    s_lshr_b32 s45, s3, 4
    s_lshl_b32 s45, s45, 1
    v_mov_b32 v8, s45
    buffer_load_ushort v56, v8, s[56:59], 0 offen
L_notree1:
    buffer_load_dwordx4 a[0:3], v1, s[8:11], s20 offen offset:0 nt
    buffer_load_dwordx4 a[4:7], v1, s[8:11], s20 offen offset:64 nt
    buffer_load_dwordx4 a[8:11], v1, s[8:11], s20 offen offset:128 nt
    buffer_load_dwordx4 a[12:15], v1, s[8:11], s20 offen offset:192 nt
    buffer_load_dwordx4 a[16:19], v1, s[8:11], s21 offen offset:0 nt
    buffer_load_dwordx4 a[20:23], v1, s[8:11], s21 offen offset:64 nt
    buffer_load_dwordx4 a[24:27], v1, s[8:11], s21 offen offset:128 nt
    buffer_load_dwordx4 a[28:31], v1, s[8:11], s21 offen offset:192 nt
    buffer_load_dwordx4 v[32:35], v11, s[16:19], 0 offen offset:0
    buffer_load_dwordx4 v[36:39], v11, s[16:19], 0 offen offset:64
    buffer_load_dwordx4 v[40:43], v11, s[16:19], 0 offen offset:128
    buffer_load_dwordx4 v[44:47], v11, s[16:19], 0 offen offset:192
    buffer_load_dwordx4 v[104:107], v2, s[12:15], s20 offen offset:0 nt
    buffer_load_dwordx4 v[108:111], v2, s[12:15], s20 offen offset:1024 nt
    buffer_load_dwordx4 v[112:115], v2, s[12:15], s20 offen offset:2048 nt
    buffer_load_dwordx4 v[116:119], v2, s[12:15], s20 offen offset:3072 nt
    buffer_load_dwordx4 v[120:123], v2, s[12:15], s21 offen offset:0 nt
    buffer_load_dwordx4 v[124:127], v2, s[12:15], s21 offen offset:1024 nt
    buffer_load_dwordx4 v[128:131], v2, s[12:15], s21 offen offset:2048 nt
    buffer_load_dwordx4 v[132:135], v2, s[12:15], s21 offen offset:3072 nt
    s_add_u32 s46, s46, 1
    s_and_b32 s47, s46, 7
    s_cmp_eq_u32 s47, 0
    s_cselect_b32 s47, s62, s63
    s_add_u32 s20, s20, s47
    s_add_u32 s21, s20, 4096
    buffer_load_dwordx4 a[32:35], v1, s[8:11], s20 offen offset:0 nt
    buffer_load_dwordx4 a[36:39], v1, s[8:11], s20 offen offset:64 nt
    buffer_load_dwordx4 a[40:43], v1, s[8:11], s20 offen offset:128 nt
    buffer_load_dwordx4 a[44:47], v1, s[8:11], s20 offen offset:192 nt
    buffer_load_dwordx4 a[48:51], v1, s[8:11], s21 offen offset:0 nt
    buffer_load_dwordx4 a[52:55], v1, s[8:11], s21 offen offset:64 nt
    buffer_load_dwordx4 a[56:59], v1, s[8:11], s21 offen offset:128 nt
    buffer_load_dwordx4 a[60:63], v1, s[8:11], s21 offen offset:192 nt
    buffer_load_dwordx4 v[136:139], v2, s[12:15], s20 offen offset:0 nt
    buffer_load_dwordx4 v[140:143], v2, s[12:15], s20 offen offset:1024 nt
    buffer_load_dwordx4 v[144:147], v2, s[12:15], s20 offen offset:2048 nt
    buffer_load_dwordx4 v[148:151], v2, s[12:15], s20 offen offset:3072 nt
    buffer_load_dwordx4 v[152:155], v2, s[12:15], s21 offen offset:0 nt
    buffer_load_dwordx4 v[156:159], v2, s[12:15], s21 offen offset:1024 nt
    buffer_load_dwordx4 v[160:163], v2, s[12:15], s21 offen offset:2048 nt
    buffer_load_dwordx4 v[164:167], v2, s[12:15], s21 offen offset:3072 nt
    s_add_u32 s46, s46, 1
    s_and_b32 s47, s46, 7
    s_cmp_eq_u32 s47, 0
    s_cselect_b32 s47, s62, s63
    s_add_u32 s20, s20, s47
    s_add_u32 s21, s20, 4096
    buffer_load_dwordx4 a[64:67], v1, s[8:11], s20 offen offset:0 nt
    buffer_load_dwordx4 a[68:71], v1, s[8:11], s20 offen offset:64 nt
    buffer_load_dwordx4 a[72:75], v1, s[8:11], s20 offen offset:128 nt
    buffer_load_dwordx4 a[76:79], v1, s[8:11], s20 offen offset:192 nt
    buffer_load_dwordx4 a[80:83], v1, s[8:11], s21 offen offset:0 nt
    buffer_load_dwordx4 a[84:87], v1, s[8:11], s21 offen offset:64 nt
    buffer_load_dwordx4 a[88:91], v1, s[8:11], s21 offen offset:128 nt
    buffer_load_dwordx4 a[92:95], v1, s[8:11], s21 offen offset:192 nt
    buffer_load_dwordx4 v[168:171], v2, s[12:15], s20 offen offset:0 nt
    buffer_load_dwordx4 v[172:175], v2, s[12:15], s20 offen offset:1024 nt
    buffer_load_dwordx4 v[176:179], v2, s[12:15], s20 offen offset:2048 nt
    buffer_load_dwordx4 v[180:183], v2, s[12:15], s20 offen offset:3072 nt
    buffer_load_dwordx4 v[184:187], v2, s[12:15], s21 offen offset:0 nt
    buffer_load_dwordx4 v[188:191], v2, s[12:15], s21 offen offset:1024 nt
    buffer_load_dwordx4 v[192:195], v2, s[12:15], s21 offen offset:2048 nt
    buffer_load_dwordx4 v[196:199], v2, s[12:15], s21 offen offset:3072 nt
    s_add_u32 s46, s46, 1
    s_and_b32 s47, s46, 7
    s_cmp_eq_u32 s47, 0
    s_cselect_b32 s47, s62, s63
    s_add_u32 s20, s20, s47
    s_add_u32 s21, s20, 4096
    s_mov_b32 s6, 0x3e0293ee
    s_mov_b32 s70, 0x40faf233
    s_mov_b32 s7, 0x05040100
    s_mov_b32 s23, 0x07060302
    v_mov_b32 v4, 0xff7fffff
    v_mov_b32 v20, 0xff7fffff
    v_mov_b32 v5, 0
    v_mov_b32 v24, 0
    v_mov_b32 v28, 0x3f803f80
    v_mov_b32 v25, 0
    v_mov_b32 v29, 0x3f803f80
    v_mov_b32 v26, 0
    v_mov_b32 v30, 0x3f803f80
    v_mov_b32 v27, 0
    v_mov_b32 v31, 0x3f803f80
    v_mov_b32 v72, 0
    v_mov_b32 v73, 0
    v_mov_b32 v74, 0
    v_mov_b32 v75, 0
    v_mov_b32 v76, 0
    v_mov_b32 v77, 0
    v_mov_b32 v78, 0
    v_mov_b32 v79, 0
    v_mov_b32 v80, 0
    v_mov_b32 v81, 0
    v_mov_b32 v82, 0
    v_mov_b32 v83, 0
    v_mov_b32 v84, 0
    v_mov_b32 v85, 0
    v_mov_b32 v86, 0
    v_mov_b32 v87, 0
    v_mov_b32 v88, 0
    v_mov_b32 v89, 0
    v_mov_b32 v90, 0
    v_mov_b32 v91, 0
    v_mov_b32 v92, 0
    v_mov_b32 v93, 0
    v_mov_b32 v94, 0
    v_mov_b32 v95, 0
    v_mov_b32 v96, 0
    v_mov_b32 v97, 0
    v_mov_b32 v98, 0
    v_mov_b32 v99, 0
    v_mov_b32 v100, 0
    v_mov_b32 v101, 0
    v_mov_b32 v102, 0
    v_mov_b32 v103, 0
    s_lshl_b32 s44, s3, 12
    s_add_u32 s56, s40, s44
    s_addc_u32 s57, s41, 0
    s_mov_b32 s58, 4096
    s_mov_b32 s59, 0x00020000
    v_cmp_eq_u32 vcc, 0, v3
    v_mov_b32 v6, 0x7ffffff0
    v_mov_b32 v60, -1
    v_mov_b32 v61, -1
    v_mov_b32 v62, -1
    v_mov_b32 v63, -1
    v_cndmask_b32 v13, v6, 0, vcc
    s_lshl_b32 s44, s4, 11
    v_add_u32 v6, 1024, v13
    buffer_store_dwordx4 v[60:63], v2, s[56:59], s44 offen sc0 sc1
    buffer_store_dwordx4 v[60:63], v6, s[56:59], s44 offen sc0 sc1
    s_mov_b32 s64, s38
    s_mov_b32 s65, s39
    s_mov_b32 s66, 256
    s_mov_b32 s67, 0x00020000
L_noclear:
    s_cmp_lg_u32 s60, 0
    s_cbranch_scc1 L_notree2
    s_waitcnt vmcnt(54)
    v_lshlrev_b32 v6, 16, v48
    v_lshlrev_b32 v7, 16, v50
    v_mul_f32 v10, v6, v7
    v_and_b32 v6, 0xffff0000, v48
    v_and_b32 v7, 0xffff0000, v50
    v_fma_f32 v10, v6, v7, v10
    v_lshlrev_b32 v6, 16, v49
    v_lshlrev_b32 v7, 16, v51
    v_fma_f32 v10, v6, v7, v10
    v_and_b32 v6, 0xffff0000, v49
    v_and_b32 v7, 0xffff0000, v51
    v_fma_f32 v10, v6, v7, v10
    s_nop 1
    v_add_f32_dpp v10, v10, v10 row_ror:8 row_mask:0xf bank_mask:0xf
    s_nop 1
    v_add_f32_dpp v10, v10, v10 row_ror:4 row_mask:0xf bank_mask:0xf
    s_nop 1
    v_add_f32_dpp v10, v10, v10 row_ror:2 row_mask:0xf bank_mask:0xf
    s_nop 1
    v_add_f32_dpp v10, v10, v10 row_ror:1 row_mask:0xf bank_mask:0xf
    v_mov_b32 v7, v10
    s_nop 1
    v_permlane16_swap_b32 v10, v7
    v_add_f32 v10, v10, v7
    v_lshlrev_b32 v7, 16, v56
    v_sub_f32 v7, 1.0, v7
    v_mul_f32 v7, 0xceabfb8f, v7
    v_fma_f32 v6, v10, s6, v7
    v_mov_b32 v7, 1.0
    v_lshlrev_b32 v52, 16, v52
    v_lshlrev_b32 v53, 16, v53
    v_lshlrev_b32 v54, 16, v54
    v_lshlrev_b32 v55, 16, v55
    v_lshrrev_b32 v10, 5, v3
    v_lshlrev_b32 v10, 3, v10
    ds_write_b128 v2, v[52:55] offset:1024
    ds_write_b64 v10, v[6:7] offset:2064
    s_waitcnt lgkmcnt(0)
L_notree2:
    s_mov_b32 s22, 41
L_loop:
    s_waitcnt vmcnt(40)
    v_mfma_f32_16x16x32_bf16 v[48:51], a[0:3], v[32:35], 0
    v_mfma_f32_16x16x32_bf16 v[52:55], a[16:19], v[32:35], 0
    v_mfma_f32_16x16x32_bf16 v[48:51], a[4:7], v[36:39], v[48:51]
    v_mfma_f32_16x16x32_bf16 v[52:55], a[20:23], v[36:39], v[52:55]
    v_mfma_f32_16x16x32_bf16 v[48:51], a[8:11], v[40:43], v[48:51]
    v_mfma_f32_16x16x32_bf16 v[52:55], a[24:27], v[40:43], v[52:55]
    v_mfma_f32_16x16x32_bf16 v[48:51], a[12:15], v[44:47], v[48:51]
    v_mfma_f32_16x16x32_bf16 v[52:55], a[28:31], v[44:47], v[52:55]
    buffer_load_dwordx4 a[0:3], v1, s[8:11], s20 offen offset:0 nt
    buffer_load_dwordx4 a[4:7], v1, s[8:11], s20 offen offset:64 nt
    s_nop 5
    v_max3_f32 v6, v48, v49, v50
    v_max3_f32 v7, v51, v52, v53
    v_max3_f32 v6, v6, v54, v55
    v_max_f32 v6, v6, v7
    v_cmp_gt_f32 vcc, v6, v20
    s_cbranch_vccnz L_rare_m0
L_back_m0:
    v_fma_f32 v48, v48, s6, -v4
    v_fma_f32 v49, v49, s6, -v4
    v_fma_f32 v50, v50, s6, -v4
    v_fma_f32 v51, v51, s6, -v4
    buffer_load_dwordx4 a[8:11], v1, s[8:11], s20 offen offset:128 nt
    v_fma_f32 v52, v52, s6, -v4
    v_fma_f32 v53, v53, s6, -v4
    v_fma_f32 v54, v54, s6, -v4
    v_fma_f32 v55, v55, s6, -v4
    buffer_load_dwordx4 a[12:15], v1, s[8:11], s20 offen offset:192 nt
    v_exp_f32 v48, v48
    v_exp_f32 v49, v49
    buffer_load_dwordx4 a[16:19], v1, s[8:11], s21 offen offset:0 nt
    v_exp_f32 v50, v50
    v_exp_f32 v51, v51
    buffer_load_dwordx4 a[20:23], v1, s[8:11], s21 offen offset:64 nt
    v_exp_f32 v52, v52
    v_exp_f32 v53, v53
    buffer_load_dwordx4 a[24:27], v1, s[8:11], s21 offen offset:128 nt
    v_exp_f32 v54, v54
    v_exp_f32 v55, v55
    buffer_load_dwordx4 a[28:31], v1, s[8:11], s21 offen offset:192 nt
    v_cvt_pk_bf16_f32 v56, v48, v49
    v_cvt_pk_bf16_f32 v57, v50, v51
    v_cvt_pk_bf16_f32 v58, v52, v53
    v_cvt_pk_bf16_f32 v59, v54, v55
    s_waitcnt vmcnt(40)
    v_perm_b32 v60, v108, v104, s7
    v_perm_b32 v61, v116, v112, s7
    v_perm_b32 v62, v124, v120, s7
    v_perm_b32 v63, v132, v128, s7
    v_mfma_f32_16x16x32_bf16 v[24:27], v[28:31], v[56:59], v[24:27]
    v_perm_b32 v64, v108, v104, s23
    v_perm_b32 v65, v116, v112, s23
    v_perm_b32 v66, v124, v120, s23
    v_perm_b32 v67, v132, v128, s23
    v_mfma_f32_16x16x32_bf16 v[72:75], v[60:63], v[56:59], v[72:75]
    v_perm_b32 v68, v109, v105, s7
    v_perm_b32 v69, v117, v113, s7
    v_perm_b32 v70, v125, v121, s7
    v_perm_b32 v71, v133, v129, s7
    v_mfma_f32_16x16x32_bf16 v[76:79], v[64:67], v[56:59], v[76:79]
    v_perm_b32 v60, v109, v105, s23
    v_perm_b32 v61, v117, v113, s23
    v_perm_b32 v62, v125, v121, s23
    v_perm_b32 v63, v133, v129, s23
    v_mfma_f32_16x16x32_bf16 v[80:83], v[68:71], v[56:59], v[80:83]
    v_perm_b32 v64, v110, v106, s7
    v_perm_b32 v65, v118, v114, s7
    v_perm_b32 v66, v126, v122, s7
    v_perm_b32 v67, v134, v130, s7
    v_mfma_f32_16x16x32_bf16 v[84:87], v[60:63], v[56:59], v[84:87]
    v_perm_b32 v68, v110, v106, s23
    v_perm_b32 v69, v118, v114, s23
    v_perm_b32 v70, v126, v122, s23
    v_perm_b32 v71, v134, v130, s23
    v_mfma_f32_16x16x32_bf16 v[88:91], v[64:67], v[56:59], v[88:91]
    v_perm_b32 v60, v111, v107, s7
    v_perm_b32 v61, v119, v115, s7
    v_perm_b32 v62, v127, v123, s7
    v_perm_b32 v63, v135, v131, s7
    v_mfma_f32_16x16x32_bf16 v[92:95], v[68:71], v[56:59], v[92:95]
    v_perm_b32 v64, v111, v107, s23
    v_perm_b32 v65, v119, v115, s23
    v_perm_b32 v66, v127, v123, s23
    v_perm_b32 v67, v135, v131, s23
    v_mfma_f32_16x16x32_bf16 v[96:99], v[60:63], v[56:59], v[96:99]
    s_nop 1
    v_mfma_f32_16x16x32_bf16 v[100:103], v[64:67], v[56:59], v[100:103]
    buffer_load_dwordx4 v[104:107], v2, s[12:15], s20 offen offset:0 nt
    buffer_load_dwordx4 v[108:111], v2, s[12:15], s20 offen offset:1024 nt
    buffer_load_dwordx4 v[112:115], v2, s[12:15], s20 offen offset:2048 nt
    buffer_load_dwordx4 v[116:119], v2, s[12:15], s20 offen offset:3072 nt
    buffer_load_dwordx4 v[120:123], v2, s[12:15], s21 offen offset:0 nt
    buffer_load_dwordx4 v[124:127], v2, s[12:15], s21 offen offset:1024 nt
    buffer_load_dwordx4 v[128:131], v2, s[12:15], s21 offen offset:2048 nt
    buffer_load_dwordx4 v[132:135], v2, s[12:15], s21 offen offset:3072 nt
    s_add_u32 s46, s46, 1
    s_and_b32 s47, s46, 7
    s_cmp_eq_u32 s47, 0
    s_cselect_b32 s47, s62, s63
    s_add_u32 s20, s20, s47
    s_add_u32 s21, s20, 4096
    s_waitcnt vmcnt(40)
    v_mfma_f32_16x16x32_bf16 v[48:51], a[32:35], v[32:35], 0
    v_mfma_f32_16x16x32_bf16 v[52:55], a[48:51], v[32:35], 0
    v_mfma_f32_16x16x32_bf16 v[48:51], a[36:39], v[36:39], v[48:51]
    v_mfma_f32_16x16x32_bf16 v[52:55], a[52:55], v[36:39], v[52:55]
    v_mfma_f32_16x16x32_bf16 v[48:51], a[40:43], v[40:43], v[48:51]
    v_mfma_f32_16x16x32_bf16 v[52:55], a[56:59], v[40:43], v[52:55]
    v_mfma_f32_16x16x32_bf16 v[48:51], a[44:47], v[44:47], v[48:51]
    v_mfma_f32_16x16x32_bf16 v[52:55], a[60:63], v[44:47], v[52:55]
    buffer_load_dwordx4 a[32:35], v1, s[8:11], s20 offen offset:0 nt
    buffer_load_dwordx4 a[36:39], v1, s[8:11], s20 offen offset:64 nt
    s_nop 5
    v_max3_f32 v6, v48, v49, v50
    v_max3_f32 v7, v51, v52, v53
    v_max3_f32 v6, v6, v54, v55
    v_max_f32 v6, v6, v7
    v_cmp_gt_f32 vcc, v6, v20
    s_cbranch_vccnz L_rare_m1
L_back_m1:
    v_fma_f32 v48, v48, s6, -v4
    v_fma_f32 v49, v49, s6, -v4
    v_fma_f32 v50, v50, s6, -v4
    v_fma_f32 v51, v51, s6, -v4
    buffer_load_dwordx4 a[40:43], v1, s[8:11], s20 offen offset:128 nt
    v_fma_f32 v52, v52, s6, -v4
    v_fma_f32 v53, v53, s6, -v4
    v_fma_f32 v54, v54, s6, -v4
    v_fma_f32 v55, v55, s6, -v4
    buffer_load_dwordx4 a[44:47], v1, s[8:11], s20 offen offset:192 nt
    v_exp_f32 v48, v48
    v_exp_f32 v49, v49
    buffer_load_dwordx4 a[48:51], v1, s[8:11], s21 offen offset:0 nt
    v_exp_f32 v50, v50
    v_exp_f32 v51, v51
    buffer_load_dwordx4 a[52:55], v1, s[8:11], s21 offen offset:64 nt
    v_exp_f32 v52, v52
    v_exp_f32 v53, v53
    buffer_load_dwordx4 a[56:59], v1, s[8:11], s21 offen offset:128 nt
    v_exp_f32 v54, v54
    v_exp_f32 v55, v55
    buffer_load_dwordx4 a[60:63], v1, s[8:11], s21 offen offset:192 nt
    v_cvt_pk_bf16_f32 v56, v48, v49
    v_cvt_pk_bf16_f32 v57, v50, v51
    v_cvt_pk_bf16_f32 v58, v52, v53
    v_cvt_pk_bf16_f32 v59, v54, v55
    s_waitcnt vmcnt(40)
    v_perm_b32 v60, v140, v136, s7
    v_perm_b32 v61, v148, v144, s7
    v_perm_b32 v62, v156, v152, s7
    v_perm_b32 v63, v164, v160, s7
    v_mfma_f32_16x16x32_bf16 v[24:27], v[28:31], v[56:59], v[24:27]
    v_perm_b32 v64, v140, v136, s23
    v_perm_b32 v65, v148, v144, s23
    v_perm_b32 v66, v156, v152, s23
    v_perm_b32 v67, v164, v160, s23
    v_mfma_f32_16x16x32_bf16 v[72:75], v[60:63], v[56:59], v[72:75]
    v_perm_b32 v68, v141, v137, s7
    v_perm_b32 v69, v149, v145, s7
    v_perm_b32 v70, v157, v153, s7
    v_perm_b32 v71, v165, v161, s7
    v_mfma_f32_16x16x32_bf16 v[76:79], v[64:67], v[56:59], v[76:79]
    v_perm_b32 v60, v141, v137, s23
    v_perm_b32 v61, v149, v145, s23
    v_perm_b32 v62, v157, v153, s23
    v_perm_b32 v63, v165, v161, s23
    v_mfma_f32_16x16x32_bf16 v[80:83], v[68:71], v[56:59], v[80:83]
    v_perm_b32 v64, v142, v138, s7
    v_perm_b32 v65, v150, v146, s7
    v_perm_b32 v66, v158, v154, s7
    v_perm_b32 v67, v166, v162, s7
    v_mfma_f32_16x16x32_bf16 v[84:87], v[60:63], v[56:59], v[84:87]
    v_perm_b32 v68, v142, v138, s23
    v_perm_b32 v69, v150, v146, s23
    v_perm_b32 v70, v158, v154, s23
    v_perm_b32 v71, v166, v162, s23
    v_mfma_f32_16x16x32_bf16 v[88:91], v[64:67], v[56:59], v[88:91]
    v_perm_b32 v60, v143, v139, s7
    v_perm_b32 v61, v151, v147, s7
    v_perm_b32 v62, v159, v155, s7
    v_perm_b32 v63, v167, v163, s7
    v_mfma_f32_16x16x32_bf16 v[92:95], v[68:71], v[56:59], v[92:95]
    v_perm_b32 v64, v143, v139, s23
    v_perm_b32 v65, v151, v147, s23
    v_perm_b32 v66, v159, v155, s23
    v_perm_b32 v67, v167, v163, s23
    v_mfma_f32_16x16x32_bf16 v[96:99], v[60:63], v[56:59], v[96:99]
    s_nop 1
    v_mfma_f32_16x16x32_bf16 v[100:103], v[64:67], v[56:59], v[100:103]
    buffer_load_dwordx4 v[136:139], v2, s[12:15], s20 offen offset:0 nt
    buffer_load_dwordx4 v[140:143], v2, s[12:15], s20 offen offset:1024 nt
    buffer_load_dwordx4 v[144:147], v2, s[12:15], s20 offen offset:2048 nt
    buffer_load_dwordx4 v[148:151], v2, s[12:15], s20 offen offset:3072 nt
    buffer_load_dwordx4 v[152:155], v2, s[12:15], s21 offen offset:0 nt
    buffer_load_dwordx4 v[156:159], v2, s[12:15], s21 offen offset:1024 nt
    buffer_load_dwordx4 v[160:163], v2, s[12:15], s21 offen offset:2048 nt
    buffer_load_dwordx4 v[164:167], v2, s[12:15], s21 offen offset:3072 nt
    s_add_u32 s46, s46, 1
    s_and_b32 s47, s46, 7
    s_cmp_eq_u32 s47, 0
    s_cselect_b32 s47, s62, s63
    s_add_u32 s20, s20, s47
    s_add_u32 s21, s20, 4096
    s_waitcnt vmcnt(40)
    v_mfma_f32_16x16x32_bf16 v[48:51], a[64:67], v[32:35], 0
    v_mfma_f32_16x16x32_bf16 v[52:55], a[80:83], v[32:35], 0
    v_mfma_f32_16x16x32_bf16 v[48:51], a[68:71], v[36:39], v[48:51]
    v_mfma_f32_16x16x32_bf16 v[52:55], a[84:87], v[36:39], v[52:55]
    v_mfma_f32_16x16x32_bf16 v[48:51], a[72:75], v[40:43], v[48:51]
    v_mfma_f32_16x16x32_bf16 v[52:55], a[88:91], v[40:43], v[52:55]
    v_mfma_f32_16x16x32_bf16 v[48:51], a[76:79], v[44:47], v[48:51]
    v_mfma_f32_16x16x32_bf16 v[52:55], a[92:95], v[44:47], v[52:55]
    buffer_load_dwordx4 a[64:67], v1, s[8:11], s20 offen offset:0 nt
    buffer_load_dwordx4 a[68:71], v1, s[8:11], s20 offen offset:64 nt
    s_nop 5
    v_max3_f32 v6, v48, v49, v50
    v_max3_f32 v7, v51, v52, v53
    v_max3_f32 v6, v6, v54, v55
    v_max_f32 v6, v6, v7
    v_cmp_gt_f32 vcc, v6, v20
    s_cbranch_vccnz L_rare_m2
L_back_m2:
    v_fma_f32 v48, v48, s6, -v4
    v_fma_f32 v49, v49, s6, -v4
    v_fma_f32 v50, v50, s6, -v4
    v_fma_f32 v51, v51, s6, -v4
    buffer_load_dwordx4 a[72:75], v1, s[8:11], s20 offen offset:128 nt
    v_fma_f32 v52, v52, s6, -v4
    v_fma_f32 v53, v53, s6, -v4
    v_fma_f32 v54, v54, s6, -v4
    v_fma_f32 v55, v55, s6, -v4
    buffer_load_dwordx4 a[76:79], v1, s[8:11], s20 offen offset:192 nt
    v_exp_f32 v48, v48
    v_exp_f32 v49, v49
    buffer_load_dwordx4 a[80:83], v1, s[8:11], s21 offen offset:0 nt
    v_exp_f32 v50, v50
    v_exp_f32 v51, v51
    buffer_load_dwordx4 a[84:87], v1, s[8:11], s21 offen offset:64 nt
    v_exp_f32 v52, v52
    v_exp_f32 v53, v53
    buffer_load_dwordx4 a[88:91], v1, s[8:11], s21 offen offset:128 nt
    v_exp_f32 v54, v54
    v_exp_f32 v55, v55
    buffer_load_dwordx4 a[92:95], v1, s[8:11], s21 offen offset:192 nt
    v_cvt_pk_bf16_f32 v56, v48, v49
    v_cvt_pk_bf16_f32 v57, v50, v51
    v_cvt_pk_bf16_f32 v58, v52, v53
    v_cvt_pk_bf16_f32 v59, v54, v55
    s_waitcnt vmcnt(40)
    v_perm_b32 v60, v172, v168, s7
    v_perm_b32 v61, v180, v176, s7
    v_perm_b32 v62, v188, v184, s7
    v_perm_b32 v63, v196, v192, s7
    v_mfma_f32_16x16x32_bf16 v[24:27], v[28:31], v[56:59], v[24:27]
    v_perm_b32 v64, v172, v168, s23
    v_perm_b32 v65, v180, v176, s23
    v_perm_b32 v66, v188, v184, s23
    v_perm_b32 v67, v196, v192, s23
    v_mfma_f32_16x16x32_bf16 v[72:75], v[60:63], v[56:59], v[72:75]
    v_perm_b32 v68, v173, v169, s7
    v_perm_b32 v69, v181, v177, s7
    v_perm_b32 v70, v189, v185, s7
    v_perm_b32 v71, v197, v193, s7
    v_mfma_f32_16x16x32_bf16 v[76:79], v[64:67], v[56:59], v[76:79]
    v_perm_b32 v60, v173, v169, s23
    v_perm_b32 v61, v181, v177, s23
    v_perm_b32 v62, v189, v185, s23
    v_perm_b32 v63, v197, v193, s23
    v_mfma_f32_16x16x32_bf16 v[80:83], v[68:71], v[56:59], v[80:83]
    v_perm_b32 v64, v174, v170, s7
    v_perm_b32 v65, v182, v178, s7
    v_perm_b32 v66, v190, v186, s7
    v_perm_b32 v67, v198, v194, s7
    v_mfma_f32_16x16x32_bf16 v[84:87], v[60:63], v[56:59], v[84:87]
    v_perm_b32 v68, v174, v170, s23
    v_perm_b32 v69, v182, v178, s23
    v_perm_b32 v70, v190, v186, s23
    v_perm_b32 v71, v198, v194, s23
    v_mfma_f32_16x16x32_bf16 v[88:91], v[64:67], v[56:59], v[88:91]
    v_perm_b32 v60, v175, v171, s7
    v_perm_b32 v61, v183, v179, s7
    v_perm_b32 v62, v191, v187, s7
    v_perm_b32 v63, v199, v195, s7
    v_mfma_f32_16x16x32_bf16 v[92:95], v[68:71], v[56:59], v[92:95]
    v_perm_b32 v64, v175, v171, s23
    v_perm_b32 v65, v183, v179, s23
    v_perm_b32 v66, v191, v187, s23
    v_perm_b32 v67, v199, v195, s23
    v_mfma_f32_16x16x32_bf16 v[96:99], v[60:63], v[56:59], v[96:99]
    s_nop 1
    v_mfma_f32_16x16x32_bf16 v[100:103], v[64:67], v[56:59], v[100:103]
    buffer_load_dwordx4 v[168:171], v2, s[12:15], s20 offen offset:0 nt
    buffer_load_dwordx4 v[172:175], v2, s[12:15], s20 offen offset:1024 nt
    buffer_load_dwordx4 v[176:179], v2, s[12:15], s20 offen offset:2048 nt
    buffer_load_dwordx4 v[180:183], v2, s[12:15], s20 offen offset:3072 nt
    buffer_load_dwordx4 v[184:187], v2, s[12:15], s21 offen offset:0 nt
    buffer_load_dwordx4 v[188:191], v2, s[12:15], s21 offen offset:1024 nt
    buffer_load_dwordx4 v[192:195], v2, s[12:15], s21 offen offset:2048 nt
    buffer_load_dwordx4 v[196:199], v2, s[12:15], s21 offen offset:3072 nt
    s_add_u32 s46, s46, 1
    s_and_b32 s47, s46, 7
    s_cmp_eq_u32 s47, 0
    s_cselect_b32 s47, s62, s63
    s_add_u32 s20, s20, s47
    s_add_u32 s21, s20, 4096
    s_sub_u32 s22, s22, 1
    s_cmp_lg_u32 s22, 0
    s_cbranch_scc1 L_loop
    s_waitcnt vmcnt(40)
    v_mfma_f32_16x16x32_bf16 v[48:51], a[0:3], v[32:35], 0
    v_mfma_f32_16x16x32_bf16 v[52:55], a[16:19], v[32:35], 0
    v_mfma_f32_16x16x32_bf16 v[48:51], a[4:7], v[36:39], v[48:51]
    v_mfma_f32_16x16x32_bf16 v[52:55], a[20:23], v[36:39], v[52:55]
    v_mfma_f32_16x16x32_bf16 v[48:51], a[8:11], v[40:43], v[48:51]
    v_mfma_f32_16x16x32_bf16 v[52:55], a[24:27], v[40:43], v[52:55]
    v_mfma_f32_16x16x32_bf16 v[48:51], a[12:15], v[44:47], v[48:51]
    v_mfma_f32_16x16x32_bf16 v[52:55], a[28:31], v[44:47], v[52:55]
    buffer_load_dwordx4 a[0:3], v1, s[8:11], s20 offen offset:0 nt
    buffer_load_dwordx4 a[4:7], v1, s[8:11], s20 offen offset:64 nt
    s_nop 5
    v_max3_f32 v6, v48, v49, v50
    v_max3_f32 v7, v51, v52, v53
    v_max3_f32 v6, v6, v54, v55
    v_max_f32 v6, v6, v7
    v_cmp_gt_f32 vcc, v6, v20
    s_cbranch_vccnz L_rare_e0
L_back_e0:
    v_fma_f32 v48, v48, s6, -v4
    v_fma_f32 v49, v49, s6, -v4
    v_fma_f32 v50, v50, s6, -v4
    v_fma_f32 v51, v51, s6, -v4
    buffer_load_dwordx4 a[8:11], v1, s[8:11], s20 offen offset:128 nt
    v_fma_f32 v52, v52, s6, -v4
    v_fma_f32 v53, v53, s6, -v4
    v_fma_f32 v54, v54, s6, -v4
    v_fma_f32 v55, v55, s6, -v4
    buffer_load_dwordx4 a[12:15], v1, s[8:11], s20 offen offset:192 nt
    v_exp_f32 v48, v48
    v_exp_f32 v49, v49
    buffer_load_dwordx4 a[16:19], v1, s[8:11], s21 offen offset:0 nt
    v_exp_f32 v50, v50
    v_exp_f32 v51, v51
    buffer_load_dwordx4 a[20:23], v1, s[8:11], s21 offen offset:64 nt
    v_exp_f32 v52, v52
    v_exp_f32 v53, v53
    buffer_load_dwordx4 a[24:27], v1, s[8:11], s21 offen offset:128 nt
    v_exp_f32 v54, v54
    v_exp_f32 v55, v55
    buffer_load_dwordx4 a[28:31], v1, s[8:11], s21 offen offset:192 nt
    v_cvt_pk_bf16_f32 v56, v48, v49
    v_cvt_pk_bf16_f32 v57, v50, v51
    v_cvt_pk_bf16_f32 v58, v52, v53
    v_cvt_pk_bf16_f32 v59, v54, v55
    s_waitcnt vmcnt(40)
    v_perm_b32 v60, v108, v104, s7
    v_perm_b32 v61, v116, v112, s7
    v_perm_b32 v62, v124, v120, s7
    v_perm_b32 v63, v132, v128, s7
    v_mfma_f32_16x16x32_bf16 v[24:27], v[28:31], v[56:59], v[24:27]
    v_perm_b32 v64, v108, v104, s23
    v_perm_b32 v65, v116, v112, s23
    v_perm_b32 v66, v124, v120, s23
    v_perm_b32 v67, v132, v128, s23
    v_mfma_f32_16x16x32_bf16 v[72:75], v[60:63], v[56:59], v[72:75]
    v_perm_b32 v68, v109, v105, s7
    v_perm_b32 v69, v117, v113, s7
    v_perm_b32 v70, v125, v121, s7
    v_perm_b32 v71, v133, v129, s7
    v_mfma_f32_16x16x32_bf16 v[76:79], v[64:67], v[56:59], v[76:79]
    v_perm_b32 v60, v109, v105, s23
    v_perm_b32 v61, v117, v113, s23
    v_perm_b32 v62, v125, v121, s23
    v_perm_b32 v63, v133, v129, s23
    v_mfma_f32_16x16x32_bf16 v[80:83], v[68:71], v[56:59], v[80:83]
    v_perm_b32 v64, v110, v106, s7
    v_perm_b32 v65, v118, v114, s7
    v_perm_b32 v66, v126, v122, s7
    v_perm_b32 v67, v134, v130, s7
    v_mfma_f32_16x16x32_bf16 v[84:87], v[60:63], v[56:59], v[84:87]
    v_perm_b32 v68, v110, v106, s23
    v_perm_b32 v69, v118, v114, s23
    v_perm_b32 v70, v126, v122, s23
    v_perm_b32 v71, v134, v130, s23
    v_mfma_f32_16x16x32_bf16 v[88:91], v[64:67], v[56:59], v[88:91]
    v_perm_b32 v60, v111, v107, s7
    v_perm_b32 v61, v119, v115, s7
    v_perm_b32 v62, v127, v123, s7
    v_perm_b32 v63, v135, v131, s7
    v_mfma_f32_16x16x32_bf16 v[92:95], v[68:71], v[56:59], v[92:95]
    v_perm_b32 v64, v111, v107, s23
    v_perm_b32 v65, v119, v115, s23
    v_perm_b32 v66, v127, v123, s23
    v_perm_b32 v67, v135, v131, s23
    v_mfma_f32_16x16x32_bf16 v[96:99], v[60:63], v[56:59], v[96:99]
    s_nop 1
    v_mfma_f32_16x16x32_bf16 v[100:103], v[64:67], v[56:59], v[100:103]
    buffer_load_dwordx4 v[104:107], v2, s[12:15], s20 offen offset:0 nt
    buffer_load_dwordx4 v[108:111], v2, s[12:15], s20 offen offset:1024 nt
    buffer_load_dwordx4 v[112:115], v2, s[12:15], s20 offen offset:2048 nt
    buffer_load_dwordx4 v[116:119], v2, s[12:15], s20 offen offset:3072 nt
    buffer_load_dwordx4 v[120:123], v2, s[12:15], s21 offen offset:0 nt
    buffer_load_dwordx4 v[124:127], v2, s[12:15], s21 offen offset:1024 nt
    buffer_load_dwordx4 v[128:131], v2, s[12:15], s21 offen offset:2048 nt
    buffer_load_dwordx4 v[132:135], v2, s[12:15], s21 offen offset:3072 nt
    s_add_u32 s46, s46, 1
    s_and_b32 s47, s46, 7
    s_cmp_eq_u32 s47, 0
    s_cselect_b32 s47, s62, s63
    s_add_u32 s20, s20, s47
    s_add_u32 s21, s20, 4096
    s_waitcnt vmcnt(40)
    v_mfma_f32_16x16x32_bf16 v[48:51], a[32:35], v[32:35], 0
    v_mfma_f32_16x16x32_bf16 v[52:55], a[48:51], v[32:35], 0
    v_mfma_f32_16x16x32_bf16 v[48:51], a[36:39], v[36:39], v[48:51]
    v_mfma_f32_16x16x32_bf16 v[52:55], a[52:55], v[36:39], v[52:55]
    v_mfma_f32_16x16x32_bf16 v[48:51], a[40:43], v[40:43], v[48:51]
    v_mfma_f32_16x16x32_bf16 v[52:55], a[56:59], v[40:43], v[52:55]
    v_mfma_f32_16x16x32_bf16 v[48:51], a[44:47], v[44:47], v[48:51]
    v_mfma_f32_16x16x32_bf16 v[52:55], a[60:63], v[44:47], v[52:55]
    buffer_load_dwordx4 a[32:35], v1, s[8:11], s20 offen offset:0 nt
    buffer_load_dwordx4 a[36:39], v1, s[8:11], s20 offen offset:64 nt
    s_nop 5
    v_max3_f32 v6, v48, v49, v50
    v_max3_f32 v7, v51, v52, v53
    v_max3_f32 v6, v6, v54, v55
    v_max_f32 v6, v6, v7
    v_cmp_gt_f32 vcc, v6, v20
    s_cbranch_vccnz L_rare_e1
L_back_e1:
    v_fma_f32 v48, v48, s6, -v4
    v_fma_f32 v49, v49, s6, -v4
    v_fma_f32 v50, v50, s6, -v4
    v_fma_f32 v51, v51, s6, -v4
    buffer_load_dwordx4 a[40:43], v1, s[8:11], s20 offen offset:128 nt
    v_fma_f32 v52, v52, s6, -v4
    v_fma_f32 v53, v53, s6, -v4
    v_fma_f32 v54, v54, s6, -v4
    v_fma_f32 v55, v55, s6, -v4
    buffer_load_dwordx4 a[44:47], v1, s[8:11], s20 offen offset:192 nt
    v_exp_f32 v48, v48
    v_exp_f32 v49, v49
    buffer_load_dwordx4 a[48:51], v1, s[8:11], s21 offen offset:0 nt
    v_exp_f32 v50, v50
    v_exp_f32 v51, v51
    buffer_load_dwordx4 a[52:55], v1, s[8:11], s21 offen offset:64 nt
    v_exp_f32 v52, v52
    v_exp_f32 v53, v53
    buffer_load_dwordx4 a[56:59], v1, s[8:11], s21 offen offset:128 nt
    v_exp_f32 v54, v54
    v_exp_f32 v55, v55
    buffer_load_dwordx4 a[60:63], v1, s[8:11], s21 offen offset:192 nt
    v_cvt_pk_bf16_f32 v56, v48, v49
    v_cvt_pk_bf16_f32 v57, v50, v51
    v_cvt_pk_bf16_f32 v58, v52, v53
    v_cvt_pk_bf16_f32 v59, v54, v55
    s_waitcnt vmcnt(40)
    v_perm_b32 v60, v140, v136, s7
    v_perm_b32 v61, v148, v144, s7
    v_perm_b32 v62, v156, v152, s7
    v_perm_b32 v63, v164, v160, s7
    v_mfma_f32_16x16x32_bf16 v[24:27], v[28:31], v[56:59], v[24:27]
    v_perm_b32 v64, v140, v136, s23
    v_perm_b32 v65, v148, v144, s23
    v_perm_b32 v66, v156, v152, s23
    v_perm_b32 v67, v164, v160, s23
    v_mfma_f32_16x16x32_bf16 v[72:75], v[60:63], v[56:59], v[72:75]
    v_perm_b32 v68, v141, v137, s7
    v_perm_b32 v69, v149, v145, s7
    v_perm_b32 v70, v157, v153, s7
    v_perm_b32 v71, v165, v161, s7
    v_mfma_f32_16x16x32_bf16 v[76:79], v[64:67], v[56:59], v[76:79]
    v_perm_b32 v60, v141, v137, s23
    v_perm_b32 v61, v149, v145, s23
    v_perm_b32 v62, v157, v153, s23
    v_perm_b32 v63, v165, v161, s23
    v_mfma_f32_16x16x32_bf16 v[80:83], v[68:71], v[56:59], v[80:83]
    v_perm_b32 v64, v142, v138, s7
    v_perm_b32 v65, v150, v146, s7
    v_perm_b32 v66, v158, v154, s7
    v_perm_b32 v67, v166, v162, s7
    v_mfma_f32_16x16x32_bf16 v[84:87], v[60:63], v[56:59], v[84:87]
    v_perm_b32 v68, v142, v138, s23
    v_perm_b32 v69, v150, v146, s23
    v_perm_b32 v70, v158, v154, s23
    v_perm_b32 v71, v166, v162, s23
    v_mfma_f32_16x16x32_bf16 v[88:91], v[64:67], v[56:59], v[88:91]
    v_perm_b32 v60, v143, v139, s7
    v_perm_b32 v61, v151, v147, s7
    v_perm_b32 v62, v159, v155, s7
    v_perm_b32 v63, v167, v163, s7
    v_mfma_f32_16x16x32_bf16 v[92:95], v[68:71], v[56:59], v[92:95]
    v_perm_b32 v64, v143, v139, s23
    v_perm_b32 v65, v151, v147, s23
    v_perm_b32 v66, v159, v155, s23
    v_perm_b32 v67, v167, v163, s23
    v_mfma_f32_16x16x32_bf16 v[96:99], v[60:63], v[56:59], v[96:99]
    s_nop 1
    v_mfma_f32_16x16x32_bf16 v[100:103], v[64:67], v[56:59], v[100:103]
    buffer_load_dwordx4 v[136:139], v2, s[12:15], s20 offen offset:0 nt
    buffer_load_dwordx4 v[140:143], v2, s[12:15], s20 offen offset:1024 nt
    buffer_load_dwordx4 v[144:147], v2, s[12:15], s20 offen offset:2048 nt
    buffer_load_dwordx4 v[148:151], v2, s[12:15], s20 offen offset:3072 nt
    buffer_load_dwordx4 v[152:155], v2, s[12:15], s21 offen offset:0 nt
    buffer_load_dwordx4 v[156:159], v2, s[12:15], s21 offen offset:1024 nt
    buffer_load_dwordx4 v[160:163], v2, s[12:15], s21 offen offset:2048 nt
    buffer_load_dwordx4 v[164:167], v2, s[12:15], s21 offen offset:3072 nt
    s_add_u32 s46, s46, 1
    s_and_b32 s47, s46, 7
    s_cmp_eq_u32 s47, 0
    s_cselect_b32 s47, s62, s63
    s_add_u32 s20, s20, s47
    s_add_u32 s21, s20, 4096
    s_and_b32 s61, s3, 1
    s_lshl_b32 s61, s61, 4
    s_lshl_b32 s44, 1, s61
    v_mov_b32 v12, s44
    s_lshr_b32 s44, s3, 1
    s_lshl_b32 s44, s44, 2
    v_add_u32 v6, s44, v13
    buffer_atomic_add v12, v6, s[64:67], 0 offen sc0
L_noarr:
    s_waitcnt vmcnt(40)
    v_mfma_f32_16x16x32_bf16 v[48:51], a[64:67], v[32:35], 0
    v_mfma_f32_16x16x32_bf16 v[52:55], a[80:83], v[32:35], 0
    v_mfma_f32_16x16x32_bf16 v[48:51], a[68:71], v[36:39], v[48:51]
    v_mfma_f32_16x16x32_bf16 v[52:55], a[84:87], v[36:39], v[52:55]
    v_mfma_f32_16x16x32_bf16 v[48:51], a[72:75], v[40:43], v[48:51]
    v_mfma_f32_16x16x32_bf16 v[52:55], a[88:91], v[40:43], v[52:55]
    v_mfma_f32_16x16x32_bf16 v[48:51], a[76:79], v[44:47], v[48:51]
    v_mfma_f32_16x16x32_bf16 v[52:55], a[92:95], v[44:47], v[52:55]
    s_nop 7
    v_max3_f32 v6, v48, v49, v50
    v_max3_f32 v7, v51, v52, v53
    v_max3_f32 v6, v6, v54, v55
    v_max_f32 v6, v6, v7
    v_cmp_gt_f32 vcc, v6, v20
    s_cbranch_vccnz L_rare_e2
L_back_e2:
    v_fma_f32 v48, v48, s6, -v4
    v_fma_f32 v49, v49, s6, -v4
    v_fma_f32 v50, v50, s6, -v4
    v_fma_f32 v51, v51, s6, -v4
    v_fma_f32 v52, v52, s6, -v4
    v_fma_f32 v53, v53, s6, -v4
    v_fma_f32 v54, v54, s6, -v4
    v_fma_f32 v55, v55, s6, -v4
    v_exp_f32 v48, v48
    v_exp_f32 v49, v49
    v_exp_f32 v50, v50
    v_exp_f32 v51, v51
    v_exp_f32 v52, v52
    v_exp_f32 v53, v53
    v_exp_f32 v54, v54
    v_exp_f32 v55, v55
    v_cvt_pk_bf16_f32 v56, v48, v49
    v_cvt_pk_bf16_f32 v57, v50, v51
    v_cvt_pk_bf16_f32 v58, v52, v53
    v_cvt_pk_bf16_f32 v59, v54, v55
    s_waitcnt vmcnt(32)
    v_perm_b32 v60, v172, v168, s7
    v_perm_b32 v61, v180, v176, s7
    v_perm_b32 v62, v188, v184, s7
    v_perm_b32 v63, v196, v192, s7
    v_mfma_f32_16x16x32_bf16 v[24:27], v[28:31], v[56:59], v[24:27]
    v_perm_b32 v64, v172, v168, s23
    v_perm_b32 v65, v180, v176, s23
    v_perm_b32 v66, v188, v184, s23
    v_perm_b32 v67, v196, v192, s23
    v_mfma_f32_16x16x32_bf16 v[72:75], v[60:63], v[56:59], v[72:75]
    v_perm_b32 v68, v173, v169, s7
    v_perm_b32 v69, v181, v177, s7
    v_perm_b32 v70, v189, v185, s7
    v_perm_b32 v71, v197, v193, s7
    v_mfma_f32_16x16x32_bf16 v[76:79], v[64:67], v[56:59], v[76:79]
    v_perm_b32 v60, v173, v169, s23
    v_perm_b32 v61, v181, v177, s23
    v_perm_b32 v62, v189, v185, s23
    v_perm_b32 v63, v197, v193, s23
    v_mfma_f32_16x16x32_bf16 v[80:83], v[68:71], v[56:59], v[80:83]
    v_perm_b32 v64, v174, v170, s7
    v_perm_b32 v65, v182, v178, s7
    v_perm_b32 v66, v190, v186, s7
    v_perm_b32 v67, v198, v194, s7
    v_mfma_f32_16x16x32_bf16 v[84:87], v[60:63], v[56:59], v[84:87]
    v_perm_b32 v68, v174, v170, s23
    v_perm_b32 v69, v182, v178, s23
    v_perm_b32 v70, v190, v186, s23
    v_perm_b32 v71, v198, v194, s23
    v_mfma_f32_16x16x32_bf16 v[88:91], v[64:67], v[56:59], v[88:91]
    v_perm_b32 v60, v175, v171, s7
    v_perm_b32 v61, v183, v179, s7
    v_perm_b32 v62, v191, v187, s7
    v_perm_b32 v63, v199, v195, s7
    v_mfma_f32_16x16x32_bf16 v[92:95], v[68:71], v[56:59], v[92:95]
    v_perm_b32 v64, v175, v171, s23
    v_perm_b32 v65, v183, v179, s23
    v_perm_b32 v66, v191, v187, s23
    v_perm_b32 v67, v199, v195, s23
    v_mfma_f32_16x16x32_bf16 v[96:99], v[60:63], v[56:59], v[96:99]
    s_nop 1
    v_mfma_f32_16x16x32_bf16 v[100:103], v[64:67], v[56:59], v[100:103]
    s_waitcnt vmcnt(24)
    v_mfma_f32_16x16x32_bf16 v[48:51], a[0:3], v[32:35], 0
    v_mfma_f32_16x16x32_bf16 v[52:55], a[16:19], v[32:35], 0
    v_mfma_f32_16x16x32_bf16 v[48:51], a[4:7], v[36:39], v[48:51]
    v_mfma_f32_16x16x32_bf16 v[52:55], a[20:23], v[36:39], v[52:55]
    v_mfma_f32_16x16x32_bf16 v[48:51], a[8:11], v[40:43], v[48:51]
    v_mfma_f32_16x16x32_bf16 v[52:55], a[24:27], v[40:43], v[52:55]
    v_mfma_f32_16x16x32_bf16 v[48:51], a[12:15], v[44:47], v[48:51]
    v_mfma_f32_16x16x32_bf16 v[52:55], a[28:31], v[44:47], v[52:55]
    s_nop 7
    v_max3_f32 v6, v48, v49, v50
    v_max3_f32 v7, v51, v52, v53
    v_max3_f32 v6, v6, v54, v55
    v_max_f32 v6, v6, v7
    v_cmp_gt_f32 vcc, v6, v20
    s_cbranch_vccnz L_rare_e3
L_back_e3:
    v_fma_f32 v48, v48, s6, -v4
    v_fma_f32 v49, v49, s6, -v4
    v_fma_f32 v50, v50, s6, -v4
    v_fma_f32 v51, v51, s6, -v4
    v_fma_f32 v52, v52, s6, -v4
    v_fma_f32 v53, v53, s6, -v4
    v_fma_f32 v54, v54, s6, -v4
    v_fma_f32 v55, v55, s6, -v4
    v_exp_f32 v48, v48
    v_exp_f32 v49, v49
    v_exp_f32 v50, v50
    v_exp_f32 v51, v51
    v_exp_f32 v52, v52
    v_exp_f32 v53, v53
    v_exp_f32 v54, v54
    v_exp_f32 v55, v55
    v_cvt_pk_bf16_f32 v56, v48, v49
    v_cvt_pk_bf16_f32 v57, v50, v51
    v_cvt_pk_bf16_f32 v58, v52, v53
    v_cvt_pk_bf16_f32 v59, v54, v55
    s_waitcnt vmcnt(16)
    v_perm_b32 v60, v108, v104, s7
    v_perm_b32 v61, v116, v112, s7
    v_perm_b32 v62, v124, v120, s7
    v_perm_b32 v63, v132, v128, s7
    v_mfma_f32_16x16x32_bf16 v[24:27], v[28:31], v[56:59], v[24:27]
    v_perm_b32 v64, v108, v104, s23
    v_perm_b32 v65, v116, v112, s23
    v_perm_b32 v66, v124, v120, s23
    v_perm_b32 v67, v132, v128, s23
    v_mfma_f32_16x16x32_bf16 v[72:75], v[60:63], v[56:59], v[72:75]
    v_perm_b32 v68, v109, v105, s7
    v_perm_b32 v69, v117, v113, s7
    v_perm_b32 v70, v125, v121, s7
    v_perm_b32 v71, v133, v129, s7
    v_mfma_f32_16x16x32_bf16 v[76:79], v[64:67], v[56:59], v[76:79]
    v_perm_b32 v60, v109, v105, s23
    v_perm_b32 v61, v117, v113, s23
    v_perm_b32 v62, v125, v121, s23
    v_perm_b32 v63, v133, v129, s23
    v_mfma_f32_16x16x32_bf16 v[80:83], v[68:71], v[56:59], v[80:83]
    v_perm_b32 v64, v110, v106, s7
    v_perm_b32 v65, v118, v114, s7
    v_perm_b32 v66, v126, v122, s7
    v_perm_b32 v67, v134, v130, s7
    v_mfma_f32_16x16x32_bf16 v[84:87], v[60:63], v[56:59], v[84:87]
    v_perm_b32 v68, v110, v106, s23
    v_perm_b32 v69, v118, v114, s23
    v_perm_b32 v70, v126, v122, s23
    v_perm_b32 v71, v134, v130, s23
    v_mfma_f32_16x16x32_bf16 v[88:91], v[64:67], v[56:59], v[88:91]
    v_perm_b32 v60, v111, v107, s7
    v_perm_b32 v61, v119, v115, s7
    v_perm_b32 v62, v127, v123, s7
    v_perm_b32 v63, v135, v131, s7
    v_mfma_f32_16x16x32_bf16 v[92:95], v[68:71], v[56:59], v[92:95]
    v_perm_b32 v64, v111, v107, s23
    v_perm_b32 v65, v119, v115, s23
    v_perm_b32 v66, v127, v123, s23
    v_perm_b32 v67, v135, v131, s23
    v_mfma_f32_16x16x32_bf16 v[96:99], v[60:63], v[56:59], v[96:99]
    s_nop 1
    v_mfma_f32_16x16x32_bf16 v[100:103], v[64:67], v[56:59], v[100:103]
    s_waitcnt vmcnt(8)
    v_mfma_f32_16x16x32_bf16 v[48:51], a[32:35], v[32:35], 0
    v_mfma_f32_16x16x32_bf16 v[52:55], a[48:51], v[32:35], 0
    v_mfma_f32_16x16x32_bf16 v[48:51], a[36:39], v[36:39], v[48:51]
    v_mfma_f32_16x16x32_bf16 v[52:55], a[52:55], v[36:39], v[52:55]
    v_mfma_f32_16x16x32_bf16 v[48:51], a[40:43], v[40:43], v[48:51]
    v_mfma_f32_16x16x32_bf16 v[52:55], a[56:59], v[40:43], v[52:55]
    v_mfma_f32_16x16x32_bf16 v[48:51], a[44:47], v[44:47], v[48:51]
    v_mfma_f32_16x16x32_bf16 v[52:55], a[60:63], v[44:47], v[52:55]
    s_nop 7
    v_max3_f32 v6, v48, v49, v50
    v_max3_f32 v7, v51, v52, v53
    v_max3_f32 v6, v6, v54, v55
    v_max_f32 v6, v6, v7
    v_cmp_gt_f32 vcc, v6, v20
    s_cbranch_vccnz L_rare_e4
L_back_e4:
    v_fma_f32 v48, v48, s6, -v4
    v_fma_f32 v49, v49, s6, -v4
    v_fma_f32 v50, v50, s6, -v4
    v_fma_f32 v51, v51, s6, -v4
    v_fma_f32 v52, v52, s6, -v4
    v_fma_f32 v53, v53, s6, -v4
    v_fma_f32 v54, v54, s6, -v4
    v_fma_f32 v55, v55, s6, -v4
    v_exp_f32 v48, v48
    v_exp_f32 v49, v49
    v_exp_f32 v50, v50
    v_exp_f32 v51, v51
    v_exp_f32 v52, v52
    v_exp_f32 v53, v53
    v_exp_f32 v54, v54
    v_exp_f32 v55, v55
    v_cvt_pk_bf16_f32 v56, v48, v49
    v_cvt_pk_bf16_f32 v57, v50, v51
    v_cvt_pk_bf16_f32 v58, v52, v53
    v_cvt_pk_bf16_f32 v59, v54, v55
    s_waitcnt vmcnt(0)
    v_perm_b32 v60, v140, v136, s7
    v_perm_b32 v61, v148, v144, s7
    v_perm_b32 v62, v156, v152, s7
    v_perm_b32 v63, v164, v160, s7
    v_mfma_f32_16x16x32_bf16 v[24:27], v[28:31], v[56:59], v[24:27]
    v_perm_b32 v64, v140, v136, s23
    v_perm_b32 v65, v148, v144, s23
    v_perm_b32 v66, v156, v152, s23
    v_perm_b32 v67, v164, v160, s23
    v_mfma_f32_16x16x32_bf16 v[72:75], v[60:63], v[56:59], v[72:75]
    v_perm_b32 v68, v141, v137, s7
    v_perm_b32 v69, v149, v145, s7
    v_perm_b32 v70, v157, v153, s7
    v_perm_b32 v71, v165, v161, s7
    v_mfma_f32_16x16x32_bf16 v[76:79], v[64:67], v[56:59], v[76:79]
    v_perm_b32 v60, v141, v137, s23
    v_perm_b32 v61, v149, v145, s23
    v_perm_b32 v62, v157, v153, s23
    v_perm_b32 v63, v165, v161, s23
    v_mfma_f32_16x16x32_bf16 v[80:83], v[68:71], v[56:59], v[80:83]
    v_perm_b32 v64, v142, v138, s7
    v_perm_b32 v65, v150, v146, s7
    v_perm_b32 v66, v158, v154, s7
    v_perm_b32 v67, v166, v162, s7
    v_mfma_f32_16x16x32_bf16 v[84:87], v[60:63], v[56:59], v[84:87]
    v_perm_b32 v68, v142, v138, s23
    v_perm_b32 v69, v150, v146, s23
    v_perm_b32 v70, v158, v154, s23
    v_perm_b32 v71, v166, v162, s23
    v_mfma_f32_16x16x32_bf16 v[88:91], v[64:67], v[56:59], v[88:91]
    v_perm_b32 v60, v143, v139, s7
    v_perm_b32 v61, v151, v147, s7
    v_perm_b32 v62, v159, v155, s7
    v_perm_b32 v63, v167, v163, s7
    v_mfma_f32_16x16x32_bf16 v[92:95], v[68:71], v[56:59], v[92:95]
    v_perm_b32 v64, v143, v139, s23
    v_perm_b32 v65, v151, v147, s23
    v_perm_b32 v66, v159, v155, s23
    v_perm_b32 v67, v167, v163, s23
    v_mfma_f32_16x16x32_bf16 v[96:99], v[60:63], v[56:59], v[96:99]
    s_nop 1
    v_mfma_f32_16x16x32_bf16 v[100:103], v[64:67], v[56:59], v[100:103]
    v_readfirstlane_b32 s60, v12
    s_xor_b32 s44, s4, 1
    s_lshl_b32 s44, s44, 11
    s_lshr_b32 s60, s60, s61
    s_and_b32 s60, s60, 1
    s_cmp_eq_u32 s60, 0
    s_cbranch_scc1 L_lds
    v_lshrrev_b32 v11, 5, v3
    v_lshlrev_b32 v11, 3, v11
    buffer_load_dwordx4 v[14:17], v2, s[56:59], s44 offen sc0 sc1
    buffer_load_dwordx2 v[18:19], v11, s[56:59], s44 offen offset:1024 sc0 sc1
L_lds:
    v_and_b32 v6, 1, v3
    v_lshrrev_b32 v7, 4, v3
    v_lshlrev_b32 v10, 9, v6
    v_lshl_add_u32 v10, v7, 7, v10
    s_lshl_b32 s45, s5, 10
    v_add_u32 v10, s45, v10
    s_lshl_b32 s45, s5, 4
    s_add_u32 s45, s45, 2048
    v_lshlrev_b32 v6, 3, v6
    v_add_u32 v6, s45, v6
    v_mov_b32 v5, v24
    s_mov_b32 exec_lo, 0x00030003
    s_mov_b32 exec_hi, 0x00030003
    ds_write_b128 v10, v[72:75] offset:0
    ds_write_b128 v10, v[76:79] offset:16
    ds_write_b128 v10, v[80:83] offset:32
    ds_write_b128 v10, v[84:87] offset:48
    ds_write_b128 v10, v[88:91] offset:64
    ds_write_b128 v10, v[92:95] offset:80
    ds_write_b128 v10, v[96:99] offset:96
    ds_write_b128 v10, v[100:103] offset:112
    ds_write_b64 v6, v[4:5]
    s_mov_b64 exec, -1
    s_waitcnt lgkmcnt(0)
    v_lshrrev_b32 v7, 5, v3
    v_lshlrev_b32 v7, 3, v7
    ds_read_b64 v[112:113], v7 offset:2048
    ds_read_b64 v[114:115], v7 offset:2064
    v_lshrrev_b32 v10, 3, v3
    v_lshlrev_b32 v10, 7, v10
    v_and_b32 v11, 1, v3
    v_lshl_add_u32 v10, v11, 6, v10
    v_bfe_u32 v11, v3, 1, 2
    v_lshl_add_u32 v10, v11, 2, v10
    ds_read_b32 v104, v10 offset:0
    ds_read_b32 v105, v10 offset:16
    ds_read_b32 v106, v10 offset:32
    ds_read_b32 v107, v10 offset:48
    ds_read_b32 v108, v10 offset:1024
    ds_read_b32 v109, v10 offset:1040
    ds_read_b32 v110, v10 offset:1056
    ds_read_b32 v111, v10 offset:1072
    s_cmp_eq_u32 s4, 0
    s_waitcnt lgkmcnt(0)
    s_cbranch_scc1 L_has_tree
    v_mov_b32 v114, 0xff7fffff
    v_mov_b32 v115, 0
    v_mov_b32 v108, 0
    v_mov_b32 v109, 0
    v_mov_b32 v110, 0
    v_mov_b32 v111, 0
L_has_tree:
    v_max_f32 v4, v112, v114
    v_sub_f32 v112, v112, v4
    v_sub_f32 v114, v114, v4
    v_exp_f32 v112, v112
    v_exp_f32 v114, v114
    s_nop 0
    v_mul_f32 v5, v112, v113
    v_mul_f32 v72, v104, v112
    v_mul_f32 v73, v105, v112
    v_mul_f32 v74, v106, v112
    v_mul_f32 v75, v107, v112
    v_fma_f32 v5, v114, v115, v5
    v_fma_f32 v72, v108, v114, v72
    v_fma_f32 v73, v109, v114, v73
    v_fma_f32 v74, v110, v114, v74
    v_fma_f32 v75, v111, v114, v75
    s_cmp_lg_u32 s60, 0
    s_cbranch_scc1 L_combine
    v_min_u32 v72, 0xfffffffe, v72
    v_min_u32 v73, 0xfffffffe, v73
    v_min_u32 v74, 0xfffffffe, v74
    v_min_u32 v75, 0xfffffffe, v75
    v_min_u32 v4, 0xfffffffe, v4
    v_min_u32 v5, 0xfffffffe, v5
    s_lshl_b32 s44, s4, 11
    buffer_store_dwordx4 v[72:75], v2, s[56:59], s44 offen sc0 sc1
    buffer_store_dwordx2 v[4:5], v7, s[56:59], s44 offen offset:1024 sc0 sc1
    s_branch L_fin
L_combine:
    s_mov_b32 s22, 0x100000
    s_waitcnt vmcnt(0)
L_check:
    v_max3_u32 v6, v14, v15, v16
    v_max3_u32 v6, v6, v17, v18
    v_max_u32 v6, v6, v19
    v_cmp_eq_u32 vcc, -1, v6
    s_cbranch_vccz L_valid
    s_sub_u32 s22, s22, 1
    s_cbranch_scc1 L_valid
    s_xor_b32 s44, s4, 1
    s_lshl_b32 s44, s44, 11
    buffer_load_dwordx4 v[14:17], v2, s[56:59], s44 offen sc0 sc1
    buffer_load_dwordx2 v[18:19], v7, s[56:59], s44 offen offset:1024 sc0 sc1
    s_waitcnt vmcnt(0)
    s_branch L_check
L_valid:
    v_max_f32 v6, v4, v18
    v_sub_f32 v10, v4, v6
    v_sub_f32 v11, v18, v6
    v_exp_f32 v10, v10
    v_exp_f32 v11, v11
    s_lshl_b32 s44, s3, 9
    s_add_u32 s16, s36, s44
    s_addc_u32 s17, s37, 0
    v_mul_f32 v5, v5, v10
    v_fma_f32 v5, v19, v11, v5
    v_rcp_f32 v5, v5
    v_mul_f32 v72, v72, v10
    v_mul_f32 v73, v73, v10
    v_mul_f32 v74, v74, v10
    v_mul_f32 v75, v75, v10
    v_fma_f32 v72, v14, v11, v72
    v_fma_f32 v73, v15, v11, v73
    v_fma_f32 v74, v16, v11, v74
    v_fma_f32 v75, v17, v11, v75
    v_lshlrev_b32 v6, 3, v3
    v_mul_f32 v72, v72, v5
    v_mul_f32 v73, v73, v5
    v_mul_f32 v74, v74, v5
    v_mul_f32 v75, v75, v5
    v_cvt_pk_bf16_f32 v56, v72, v73
    v_cvt_pk_bf16_f32 v57, v74, v75
    buffer_store_dwordx2 v[56:57], v6, s[16:19], 0 offen
L_fin:
L_end:
    s_endpgm
L_rare_m0:
    v_mov_b32 v7, v6
    s_nop 1
    v_permlane32_swap_b32 v6, v7
    v_max_f32 v6, v6, v7
    v_mov_b32 v7, v6
    s_nop 1
    v_permlane16_swap_b32 v6, v7
    v_max_f32 v6, v6, v7
    v_mul_f32 v6, s6, v6
    v_max_f32 v9, v4, v6
    v_sub_f32 v7, v4, v9
    v_exp_f32 v8, v7
    v_mov_b32 v4, v9
    v_add_f32 v20, 0x41000000, v9
    v_mul_f32 v20, s70, v20
    v_mul_f32 v24, v24, v8
    v_mul_f32 v25, v25, v8
    v_mul_f32 v26, v26, v8
    v_mul_f32 v27, v27, v8
    v_mul_f32 v72, v72, v8
    v_mul_f32 v73, v73, v8
    v_mul_f32 v74, v74, v8
    v_mul_f32 v75, v75, v8
    v_mul_f32 v76, v76, v8
    v_mul_f32 v77, v77, v8
    v_mul_f32 v78, v78, v8
    v_mul_f32 v79, v79, v8
    v_mul_f32 v80, v80, v8
    v_mul_f32 v81, v81, v8
    v_mul_f32 v82, v82, v8
    v_mul_f32 v83, v83, v8
    v_mul_f32 v84, v84, v8
    v_mul_f32 v85, v85, v8
    v_mul_f32 v86, v86, v8
    v_mul_f32 v87, v87, v8
    v_mul_f32 v88, v88, v8
    v_mul_f32 v89, v89, v8
    v_mul_f32 v90, v90, v8
    v_mul_f32 v91, v91, v8
    v_mul_f32 v92, v92, v8
    v_mul_f32 v93, v93, v8
    v_mul_f32 v94, v94, v8
    v_mul_f32 v95, v95, v8
    v_mul_f32 v96, v96, v8
    v_mul_f32 v97, v97, v8
    v_mul_f32 v98, v98, v8
    v_mul_f32 v99, v99, v8
    v_mul_f32 v100, v100, v8
    v_mul_f32 v101, v101, v8
    v_mul_f32 v102, v102, v8
    v_mul_f32 v103, v103, v8
    s_branch L_back_m0
L_rare_m1:
    v_mov_b32 v7, v6
    s_nop 1
    v_permlane32_swap_b32 v6, v7
    v_max_f32 v6, v6, v7
    v_mov_b32 v7, v6
    s_nop 1
    v_permlane16_swap_b32 v6, v7
    v_max_f32 v6, v6, v7
    v_mul_f32 v6, s6, v6
    v_max_f32 v9, v4, v6
    v_sub_f32 v7, v4, v9
    v_exp_f32 v8, v7
    v_mov_b32 v4, v9
    v_add_f32 v20, 0x41000000, v9
    v_mul_f32 v20, s70, v20
    v_mul_f32 v24, v24, v8
    v_mul_f32 v25, v25, v8
    v_mul_f32 v26, v26, v8
    v_mul_f32 v27, v27, v8
    v_mul_f32 v72, v72, v8
    v_mul_f32 v73, v73, v8
    v_mul_f32 v74, v74, v8
    v_mul_f32 v75, v75, v8
    v_mul_f32 v76, v76, v8
    v_mul_f32 v77, v77, v8
    v_mul_f32 v78, v78, v8
    v_mul_f32 v79, v79, v8
    v_mul_f32 v80, v80, v8
    v_mul_f32 v81, v81, v8
    v_mul_f32 v82, v82, v8
    v_mul_f32 v83, v83, v8
    v_mul_f32 v84, v84, v8
    v_mul_f32 v85, v85, v8
    v_mul_f32 v86, v86, v8
    v_mul_f32 v87, v87, v8
    v_mul_f32 v88, v88, v8
    v_mul_f32 v89, v89, v8
    v_mul_f32 v90, v90, v8
    v_mul_f32 v91, v91, v8
    v_mul_f32 v92, v92, v8
    v_mul_f32 v93, v93, v8
    v_mul_f32 v94, v94, v8
    v_mul_f32 v95, v95, v8
    v_mul_f32 v96, v96, v8
    v_mul_f32 v97, v97, v8
    v_mul_f32 v98, v98, v8
    v_mul_f32 v99, v99, v8
    v_mul_f32 v100, v100, v8
    v_mul_f32 v101, v101, v8
    v_mul_f32 v102, v102, v8
    v_mul_f32 v103, v103, v8
    s_branch L_back_m1
L_rare_m2:
    v_mov_b32 v7, v6
    s_nop 1
    v_permlane32_swap_b32 v6, v7
    v_max_f32 v6, v6, v7
    v_mov_b32 v7, v6
    s_nop 1
    v_permlane16_swap_b32 v6, v7
    v_max_f32 v6, v6, v7
    v_mul_f32 v6, s6, v6
    v_max_f32 v9, v4, v6
    v_sub_f32 v7, v4, v9
    v_exp_f32 v8, v7
    v_mov_b32 v4, v9
    v_add_f32 v20, 0x41000000, v9
    v_mul_f32 v20, s70, v20
    v_mul_f32 v24, v24, v8
    v_mul_f32 v25, v25, v8
    v_mul_f32 v26, v26, v8
    v_mul_f32 v27, v27, v8
    v_mul_f32 v72, v72, v8
    v_mul_f32 v73, v73, v8
    v_mul_f32 v74, v74, v8
    v_mul_f32 v75, v75, v8
    v_mul_f32 v76, v76, v8
    v_mul_f32 v77, v77, v8
    v_mul_f32 v78, v78, v8
    v_mul_f32 v79, v79, v8
    v_mul_f32 v80, v80, v8
    v_mul_f32 v81, v81, v8
    v_mul_f32 v82, v82, v8
    v_mul_f32 v83, v83, v8
    v_mul_f32 v84, v84, v8
    v_mul_f32 v85, v85, v8
    v_mul_f32 v86, v86, v8
    v_mul_f32 v87, v87, v8
    v_mul_f32 v88, v88, v8
    v_mul_f32 v89, v89, v8
    v_mul_f32 v90, v90, v8
    v_mul_f32 v91, v91, v8
    v_mul_f32 v92, v92, v8
    v_mul_f32 v93, v93, v8
    v_mul_f32 v94, v94, v8
    v_mul_f32 v95, v95, v8
    v_mul_f32 v96, v96, v8
    v_mul_f32 v97, v97, v8
    v_mul_f32 v98, v98, v8
    v_mul_f32 v99, v99, v8
    v_mul_f32 v100, v100, v8
    v_mul_f32 v101, v101, v8
    v_mul_f32 v102, v102, v8
    v_mul_f32 v103, v103, v8
    s_branch L_back_m2
L_rare_e0:
    v_mov_b32 v7, v6
    s_nop 1
    v_permlane32_swap_b32 v6, v7
    v_max_f32 v6, v6, v7
    v_mov_b32 v7, v6
    s_nop 1
    v_permlane16_swap_b32 v6, v7
    v_max_f32 v6, v6, v7
    v_mul_f32 v6, s6, v6
    v_max_f32 v9, v4, v6
    v_sub_f32 v7, v4, v9
    v_exp_f32 v8, v7
    v_mov_b32 v4, v9
    v_add_f32 v20, 0x41000000, v9
    v_mul_f32 v20, s70, v20
    v_mul_f32 v24, v24, v8
    v_mul_f32 v25, v25, v8
    v_mul_f32 v26, v26, v8
    v_mul_f32 v27, v27, v8
    v_mul_f32 v72, v72, v8
    v_mul_f32 v73, v73, v8
    v_mul_f32 v74, v74, v8
    v_mul_f32 v75, v75, v8
    v_mul_f32 v76, v76, v8
    v_mul_f32 v77, v77, v8
    v_mul_f32 v78, v78, v8
    v_mul_f32 v79, v79, v8
    v_mul_f32 v80, v80, v8
    v_mul_f32 v81, v81, v8
    v_mul_f32 v82, v82, v8
    v_mul_f32 v83, v83, v8
    v_mul_f32 v84, v84, v8
    v_mul_f32 v85, v85, v8
    v_mul_f32 v86, v86, v8
    v_mul_f32 v87, v87, v8
    v_mul_f32 v88, v88, v8
    v_mul_f32 v89, v89, v8
    v_mul_f32 v90, v90, v8
    v_mul_f32 v91, v91, v8
    v_mul_f32 v92, v92, v8
    v_mul_f32 v93, v93, v8
    v_mul_f32 v94, v94, v8
    v_mul_f32 v95, v95, v8
    v_mul_f32 v96, v96, v8
    v_mul_f32 v97, v97, v8
    v_mul_f32 v98, v98, v8
    v_mul_f32 v99, v99, v8
    v_mul_f32 v100, v100, v8
    v_mul_f32 v101, v101, v8
    v_mul_f32 v102, v102, v8
    v_mul_f32 v103, v103, v8
    s_branch L_back_e0
L_rare_e1:
    v_mov_b32 v7, v6
    s_nop 1
    v_permlane32_swap_b32 v6, v7
    v_max_f32 v6, v6, v7
    v_mov_b32 v7, v6
    s_nop 1
    v_permlane16_swap_b32 v6, v7
    v_max_f32 v6, v6, v7
    v_mul_f32 v6, s6, v6
    v_max_f32 v9, v4, v6
    v_sub_f32 v7, v4, v9
    v_exp_f32 v8, v7
    v_mov_b32 v4, v9
    v_add_f32 v20, 0x41000000, v9
    v_mul_f32 v20, s70, v20
    v_mul_f32 v24, v24, v8
    v_mul_f32 v25, v25, v8
    v_mul_f32 v26, v26, v8
    v_mul_f32 v27, v27, v8
    v_mul_f32 v72, v72, v8
    v_mul_f32 v73, v73, v8
    v_mul_f32 v74, v74, v8
    v_mul_f32 v75, v75, v8
    v_mul_f32 v76, v76, v8
    v_mul_f32 v77, v77, v8
    v_mul_f32 v78, v78, v8
    v_mul_f32 v79, v79, v8
    v_mul_f32 v80, v80, v8
    v_mul_f32 v81, v81, v8
    v_mul_f32 v82, v82, v8
    v_mul_f32 v83, v83, v8
    v_mul_f32 v84, v84, v8
    v_mul_f32 v85, v85, v8
    v_mul_f32 v86, v86, v8
    v_mul_f32 v87, v87, v8
    v_mul_f32 v88, v88, v8
    v_mul_f32 v89, v89, v8
    v_mul_f32 v90, v90, v8
    v_mul_f32 v91, v91, v8
    v_mul_f32 v92, v92, v8
    v_mul_f32 v93, v93, v8
    v_mul_f32 v94, v94, v8
    v_mul_f32 v95, v95, v8
    v_mul_f32 v96, v96, v8
    v_mul_f32 v97, v97, v8
    v_mul_f32 v98, v98, v8
    v_mul_f32 v99, v99, v8
    v_mul_f32 v100, v100, v8
    v_mul_f32 v101, v101, v8
    v_mul_f32 v102, v102, v8
    v_mul_f32 v103, v103, v8
    s_branch L_back_e1
L_rare_e2:
    v_mov_b32 v7, v6
    s_nop 1
    v_permlane32_swap_b32 v6, v7
    v_max_f32 v6, v6, v7
    v_mov_b32 v7, v6
    s_nop 1
    v_permlane16_swap_b32 v6, v7
    v_max_f32 v6, v6, v7
    v_mul_f32 v6, s6, v6
    v_max_f32 v9, v4, v6
    v_sub_f32 v7, v4, v9
    v_exp_f32 v8, v7
    v_mov_b32 v4, v9
    v_add_f32 v20, 0x41000000, v9
    v_mul_f32 v20, s70, v20
    v_mul_f32 v24, v24, v8
    v_mul_f32 v25, v25, v8
    v_mul_f32 v26, v26, v8
    v_mul_f32 v27, v27, v8
    v_mul_f32 v72, v72, v8
    v_mul_f32 v73, v73, v8
    v_mul_f32 v74, v74, v8
    v_mul_f32 v75, v75, v8
    v_mul_f32 v76, v76, v8
    v_mul_f32 v77, v77, v8
    v_mul_f32 v78, v78, v8
    v_mul_f32 v79, v79, v8
    v_mul_f32 v80, v80, v8
    v_mul_f32 v81, v81, v8
    v_mul_f32 v82, v82, v8
    v_mul_f32 v83, v83, v8
    v_mul_f32 v84, v84, v8
    v_mul_f32 v85, v85, v8
    v_mul_f32 v86, v86, v8
    v_mul_f32 v87, v87, v8
    v_mul_f32 v88, v88, v8
    v_mul_f32 v89, v89, v8
    v_mul_f32 v90, v90, v8
    v_mul_f32 v91, v91, v8
    v_mul_f32 v92, v92, v8
    v_mul_f32 v93, v93, v8
    v_mul_f32 v94, v94, v8
    v_mul_f32 v95, v95, v8
    v_mul_f32 v96, v96, v8
    v_mul_f32 v97, v97, v8
    v_mul_f32 v98, v98, v8
    v_mul_f32 v99, v99, v8
    v_mul_f32 v100, v100, v8
    v_mul_f32 v101, v101, v8
    v_mul_f32 v102, v102, v8
    v_mul_f32 v103, v103, v8
    s_branch L_back_e2
L_rare_e3:
    v_mov_b32 v7, v6
    s_nop 1
    v_permlane32_swap_b32 v6, v7
    v_max_f32 v6, v6, v7
    v_mov_b32 v7, v6
    s_nop 1
    v_permlane16_swap_b32 v6, v7
    v_max_f32 v6, v6, v7
    v_mul_f32 v6, s6, v6
    v_max_f32 v9, v4, v6
    v_sub_f32 v7, v4, v9
    v_exp_f32 v8, v7
    v_mov_b32 v4, v9
    v_add_f32 v20, 0x41000000, v9
    v_mul_f32 v20, s70, v20
    v_mul_f32 v24, v24, v8
    v_mul_f32 v25, v25, v8
    v_mul_f32 v26, v26, v8
    v_mul_f32 v27, v27, v8
    v_mul_f32 v72, v72, v8
    v_mul_f32 v73, v73, v8
    v_mul_f32 v74, v74, v8
    v_mul_f32 v75, v75, v8
    v_mul_f32 v76, v76, v8
    v_mul_f32 v77, v77, v8
    v_mul_f32 v78, v78, v8
    v_mul_f32 v79, v79, v8
    v_mul_f32 v80, v80, v8
    v_mul_f32 v81, v81, v8
    v_mul_f32 v82, v82, v8
    v_mul_f32 v83, v83, v8
    v_mul_f32 v84, v84, v8
    v_mul_f32 v85, v85, v8
    v_mul_f32 v86, v86, v8
    v_mul_f32 v87, v87, v8
    v_mul_f32 v88, v88, v8
    v_mul_f32 v89, v89, v8
    v_mul_f32 v90, v90, v8
    v_mul_f32 v91, v91, v8
    v_mul_f32 v92, v92, v8
    v_mul_f32 v93, v93, v8
    v_mul_f32 v94, v94, v8
    v_mul_f32 v95, v95, v8
    v_mul_f32 v96, v96, v8
    v_mul_f32 v97, v97, v8
    v_mul_f32 v98, v98, v8
    v_mul_f32 v99, v99, v8
    v_mul_f32 v100, v100, v8
    v_mul_f32 v101, v101, v8
    v_mul_f32 v102, v102, v8
    v_mul_f32 v103, v103, v8
    s_branch L_back_e3
L_rare_e4:
    v_mov_b32 v7, v6
    s_nop 1
    v_permlane32_swap_b32 v6, v7
    v_max_f32 v6, v6, v7
    v_mov_b32 v7, v6
    s_nop 1
    v_permlane16_swap_b32 v6, v7
    v_max_f32 v6, v6, v7
    v_mul_f32 v6, s6, v6
    v_max_f32 v9, v4, v6
    v_sub_f32 v7, v4, v9
    v_exp_f32 v8, v7
    v_mov_b32 v4, v9
    v_add_f32 v20, 0x41000000, v9
    v_mul_f32 v20, s70, v20
    v_mul_f32 v24, v24, v8
    v_mul_f32 v25, v25, v8
    v_mul_f32 v26, v26, v8
    v_mul_f32 v27, v27, v8
    v_mul_f32 v72, v72, v8
    v_mul_f32 v73, v73, v8
    v_mul_f32 v74, v74, v8
    v_mul_f32 v75, v75, v8
    v_mul_f32 v76, v76, v8
    v_mul_f32 v77, v77, v8
    v_mul_f32 v78, v78, v8
    v_mul_f32 v79, v79, v8
    v_mul_f32 v80, v80, v8
    v_mul_f32 v81, v81, v8
    v_mul_f32 v82, v82, v8
    v_mul_f32 v83, v83, v8
    v_mul_f32 v84, v84, v8
    v_mul_f32 v85, v85, v8
    v_mul_f32 v86, v86, v8
    v_mul_f32 v87, v87, v8
    v_mul_f32 v88, v88, v8
    v_mul_f32 v89, v89, v8
    v_mul_f32 v90, v90, v8
    v_mul_f32 v91, v91, v8
    v_mul_f32 v92, v92, v8
    v_mul_f32 v93, v93, v8
    v_mul_f32 v94, v94, v8
    v_mul_f32 v95, v95, v8
    v_mul_f32 v96, v96, v8
    v_mul_f32 v97, v97, v8
    v_mul_f32 v98, v98, v8
    v_mul_f32 v99, v99, v8
    v_mul_f32 v100, v100, v8
    v_mul_f32 v101, v101, v8
    v_mul_f32 v102, v102, v8
    v_mul_f32 v103, v103, v8
    s_branch L_back_e4
.section .rodata,"a"
.p2align 6
.amdhsa_kernel standalone__tree_speculative_verify_tree_attention_over_candidate_token_tree__sampling_kernel
  .amdhsa_next_free_vgpr 296
  .amdhsa_next_free_sgpr 80
  .amdhsa_accum_offset 200
  .amdhsa_group_segment_fixed_size 0
  .amdhsa_kernarg_size 72
  .amdhsa_user_sgpr_count 2
  .amdhsa_user_sgpr_kernarg_segment_ptr 1
  .amdhsa_system_sgpr_workgroup_id_x 1
.end_amdhsa_kernel
```
